```python
import torch

def _softmax(x, axis=-1):
    return torch.softmax(x, dim=axis)
def _gelu(x):
    return torch.nn.functional.gelu(x, approximate="tanh")
def _silu(x):
    return torch.nn.functional.silu(x)
def _sigmoid(x):
    return torch.sigmoid(x)
def _layernorm(x, axis=-1, eps=1e-5):
    m = x.mean(dim=axis, keepdim=True)
    v = x.var(dim=axis, keepdim=True, unbiased=False)
    return (x - m) / torch.sqrt(v + eps)
def _scatter_add(tgt, idx, src, axis=0):
    return tgt.clone().index_add_(axis, idx, src)
def _segment_sum(src, seg, n):
    out = torch.zeros((n,) + src.shape[1:], dtype=src.dtype)
    return out.index_add_(0, seg, src)
def _pad(x, pw):
    flat = tuple(v for pair in reversed(pw) for v in pair)
    return torch.nn.functional.pad(x, flat)

kernel_name = 'standalone__low_rank_proj_linformer__decode'

def setup_inputs():

    _w = (lambda a: (lambda t: t.to(torch.bfloat16) if t.is_floating_point() else t)(torch.as_tensor(a)))
    B, H, Sq, Skv, Dh, R = 2, 32, 1, 8192, 128, 16
    return {
        "q": _w((lambda *s: torch.randn(*s, dtype=torch.bfloat16) * 0.8)(B, H, Sq, Dh)),
        "k": _w((lambda *s: torch.randn(*s, dtype=torch.bfloat16) * 0.8)(B, H, Skv, Dh)),
        "v": _w((lambda *s: torch.randn(*s, dtype=torch.bfloat16) * 0.05)(B, H, Skv, Dh)),
        "e_proj": _w((lambda *s: torch.randn(*s, dtype=torch.bfloat16) * 0.8)(R, Skv) * (Skv ** -0.5)),
        "f_proj": _w((lambda *s: torch.randn(*s, dtype=torch.bfloat16) * 0.05)(R, Skv) * (Skv ** -0.5)),
    }

def reference(q, k, v, e_proj, f_proj):
    B, H, Sq, Dh = q.shape
    kp = torch.einsum("rn,bhnd->bhrd", e_proj, k)
    vp = torch.einsum("rn,bhnd->bhrd", f_proj, v)
    scores = torch.einsum("bhqd,bhrd->bhqr", q, kp) * (Dh ** -0.5)
    p = _softmax(scores, axis=-1)
    o = torch.einsum("bhqr,bhrd->bhqd", p, vp)
    return o
```

```asm
; @launch grid=(256,1,1) block=(192,1,1) lds=98304
.amdgcn_target "amdgcn-amd-amdhsa--gfx950"
.text
.globl standalone__low_rank_proj_linformer__decode_kernel
.p2align 8
.type standalone__low_rank_proj_linformer__decode_kernel,@function
standalone__low_rank_proj_linformer__decode_kernel:
    s_load_dwordx16 s[4:19], s[0:1], 0
    s_cmp_ge_u32 s2, 256
    s_cbranch_scc1 L_end
    v_lshrrev_b32 v3, 6, v0
    v_and_b32 v0, 63, v0
    v_readfirstlane_b32 s36, v3
    v_and_b32 v4, 15, v0
    v_lshrrev_b32 v5, 4, v0
    v_lshlrev_b32 v1, 4, v4
    v_lshl_add_u32 v1, v5, 11, v1
    v_lshlrev_b32 v2, 14, v4
    v_lshl_add_u32 v2, v5, 4, v2
    s_bfe_u32 s38, s2, 0x10002
    s_bfe_u32 s44, s2, 0x10001
    s_lshl_b32 s44, s44, 1
    s_or_b32 s38, s38, s44
    s_mov_b32 s37, 0
    s_bfe_u32 s44, s2, 0x10000
    s_lshl_b32 s44, s44, 0
    s_or_b32 s37, s37, s44
    s_bfe_u32 s44, s2, 0x10003
    s_lshl_b32 s44, s44, 1
    s_or_b32 s37, s37, s44
    s_bfe_u32 s44, s2, 0x10004
    s_lshl_b32 s44, s44, 2
    s_or_b32 s37, s37, s44
    s_bfe_u32 s44, s2, 0x10005
    s_lshl_b32 s44, s44, 3
    s_or_b32 s37, s37, s44
    s_bfe_u32 s44, s2, 0x10006
    s_lshl_b32 s44, s44, 4
    s_or_b32 s37, s37, s44
    s_bfe_u32 s44, s2, 0x10007
    s_lshl_b32 s44, s44, 5
    s_or_b32 s37, s37, s44
    s_mov_b32 s42, 0x05040100
    s_mov_b32 s43, 0x07060302
    s_lshl_b32 s44, s37, 21
    s_lshl_b32 s48, s38, 6
    s_mov_b32 s49, s36
    s_mov_b32 s22, 0x200000
    s_mov_b32 s23, 0x20000
    s_mov_b32 s30, 0x200000
    s_mov_b32 s31, 0x20000
    s_mov_b32 s26, 262144
    s_mov_b32 s27, 0x20000
    s_mov_b32 s34, 262144
    s_mov_b32 s35, 0x20000
    s_cmp_eq_u32 s36, 2
    s_cbranch_scc1 L_helper
    s_waitcnt lgkmcnt(0)
    s_add_u32 s20, s6, s44
    s_addc_u32 s21, s7, 0
    s_and_b32 s21, s21, 0xffff
    s_mov_b32 s24, s10
    s_and_b32 s25, s11, 0xffff
    s_add_u32 s45, s49, s48
    s_add_u32 s49, s49, 2
    s_lshl_b32 s40, s45, 13
    s_lshl_b32 s41, s45, 6
    buffer_load_dwordx4 v[84:87], v1, s[20:23], s40 offen offset:0 nt
    buffer_load_dwordx4 v[88:91], v1, s[20:23], s40 offen offset:256 nt
    buffer_load_dwordx4 v[92:95], v1, s[20:23], s40 offen offset:512 nt
    buffer_load_dwordx4 v[96:99], v1, s[20:23], s40 offen offset:768 nt
    buffer_load_dwordx4 v[100:103], v1, s[20:23], s40 offen offset:1024 nt
    buffer_load_dwordx4 v[104:107], v1, s[20:23], s40 offen offset:1280 nt
    buffer_load_dwordx4 v[108:111], v1, s[20:23], s40 offen offset:1536 nt
    buffer_load_dwordx4 v[112:115], v1, s[20:23], s40 offen offset:1792 nt
    buffer_load_dwordx4 v[76:79], v2, s[24:27], s41 offen
    s_add_u32 s45, s49, s48
    s_add_u32 s49, s49, 2
    s_lshl_b32 s40, s45, 13
    s_lshl_b32 s41, s45, 6
    buffer_load_dwordx4 v[116:119], v1, s[20:23], s40 offen offset:0 nt
    buffer_load_dwordx4 v[120:123], v1, s[20:23], s40 offen offset:256 nt
    buffer_load_dwordx4 v[124:127], v1, s[20:23], s40 offen offset:512 nt
    buffer_load_dwordx4 v[128:131], v1, s[20:23], s40 offen offset:768 nt
    buffer_load_dwordx4 v[132:135], v1, s[20:23], s40 offen offset:1024 nt
    buffer_load_dwordx4 v[136:139], v1, s[20:23], s40 offen offset:1280 nt
    buffer_load_dwordx4 v[140:143], v1, s[20:23], s40 offen offset:1536 nt
    buffer_load_dwordx4 v[144:147], v1, s[20:23], s40 offen offset:1792 nt
    buffer_load_dwordx4 v[80:83], v2, s[24:27], s41 offen
    s_add_u32 s28, s8, s44
    s_addc_u32 s29, s9, 0
    s_and_b32 s29, s29, 0xffff
    s_mov_b32 s32, s12
    s_and_b32 s33, s13, 0xffff
    s_lshl_b32 s45, s37, 8
    s_add_u32 s46, s4, s45
    s_addc_u32 s47, s5, 0
    v_lshlrev_b32 v3, 4, v4
    global_load_dwordx4 v[8:11], v3, s[46:47]
    s_lshl_b32 s45, s37, 7
    s_add_u32 s45, s45, 196608
    s_add_u32 s70, s18, s45
    s_addc_u32 s71, s19, 0
    s_mov_b32 s72, 1
    s_mov_b32 s73, 1
    v_mov_b32 v150, 0
    v_mov_b32 v151, 1
    v_mov_b32 v12, 0
    v_mov_b32 v13, 0
    v_mov_b32 v14, 0
    v_mov_b32 v15, 0
    v_mov_b32 v16, 0
    v_mov_b32 v17, 0
    v_mov_b32 v18, 0
    v_mov_b32 v19, 0
    v_mov_b32 v20, 0
    v_mov_b32 v21, 0
    v_mov_b32 v22, 0
    v_mov_b32 v23, 0
    v_mov_b32 v24, 0
    v_mov_b32 v25, 0
    v_mov_b32 v26, 0
    v_mov_b32 v27, 0
    v_mov_b32 v28, 0
    v_mov_b32 v29, 0
    v_mov_b32 v30, 0
    v_mov_b32 v31, 0
    v_mov_b32 v32, 0
    v_mov_b32 v33, 0
    v_mov_b32 v34, 0
    v_mov_b32 v35, 0
    v_mov_b32 v36, 0
    v_mov_b32 v37, 0
    v_mov_b32 v38, 0
    v_mov_b32 v39, 0
    v_mov_b32 v40, 0
    v_mov_b32 v41, 0
    v_mov_b32 v42, 0
    v_mov_b32 v43, 0
    s_barrier
    s_mov_b32 s39, 0
L_loop:
    s_cmp_eq_u32 s39, 15
    s_cbranch_scc0 L_nosw
    s_mov_b32 s20, s28
    s_mov_b32 s21, s29
    s_mov_b32 s24, s32
    s_mov_b32 s25, s33
    s_mov_b32 s49, s36
L_nosw:
    s_cmp_eq_u32 s39, 20
    s_cbranch_scc0 L_nolate
    v_mov_b32 v4, 0
    v_mov_b32 v5, 1
    s_mov_b64 exec, 1
    ds_add_u32 v4, v5 offset:4
    s_mov_b64 exec, -1
L_nolate:
    s_cmp_eq_u32 s39, 28
    s_cbranch_scc0 L_nook
    s_mov_b32 s50, 0
    v_mov_b32 v4, 0
L_ok:
    ds_read_b32 v5, v4 offset:8
    s_waitcnt lgkmcnt(0)
    v_readfirstlane_b32 s45, v5
    s_cmp_lg_u32 s45, 0
    s_cbranch_scc1 L_okok
    s_add_u32 s50, s50, 1
    s_cmp_ge_u32 s50, 0x400000
    s_cbranch_scc1 L_okok
    s_sleep 1
    s_branch L_ok
L_okok:
    v_lshrrev_b32 v6, 4, v0
    v_lshlrev_b32 v6, 4, v6
    ds_read_b128 v[8:11], v6 offset:64
L_nook:
    s_cmp_eq_u32 s72, 0
    s_cbranch_scc1 L_vepi
    s_waitcnt vmcnt(9)
    s_cmp_lt_u32 s39, 29
    s_cbranch_scc1 L_static0
    v_readfirstlane_b32 s3, v148
    s_and_b32 s45, s3, 3
    s_lshl_b32 s45, s45, 6
    s_lshr_b32 s46, s3, 2
    s_add_u32 s45, s45, s46
    s_add_u32 s45, s45, 56
    s_cmp_lt_u32 s3, 32
    s_cselect_b32 s72, 1, 0
    s_cselect_b32 s22, 0x200000, 0
    s_cselect_b32 s26, 0x40000, 0
    s_branch L_join0
L_static0:
    s_add_u32 s45, s49, s48
    s_add_u32 s49, s49, 2
L_join0:
    s_lshl_b32 s40, s45, 13
    s_lshl_b32 s41, s45, 6
    v_mov_b32 v152, v76
    v_mov_b32 v153, v77
    v_mov_b32 v154, v78
    v_mov_b32 v155, v79
    v_perm_b32 v44, v88, v84, s42
    v_perm_b32 v48, v88, v84, s43
    v_perm_b32 v52, v89, v85, s42
    v_perm_b32 v56, v89, v85, s43
    v_perm_b32 v60, v90, v86, s42
    v_perm_b32 v64, v90, v86, s43
    v_perm_b32 v68, v91, v87, s42
    v_perm_b32 v72, v91, v87, s43
    v_perm_b32 v45, v96, v92, s42
    v_perm_b32 v49, v96, v92, s43
    v_perm_b32 v53, v97, v93, s42
    v_perm_b32 v57, v97, v93, s43
    v_perm_b32 v61, v98, v94, s42
    v_perm_b32 v65, v98, v94, s43
    v_perm_b32 v69, v99, v95, s42
    v_perm_b32 v73, v99, v95, s43
    v_perm_b32 v46, v104, v100, s42
    v_perm_b32 v50, v104, v100, s43
    v_perm_b32 v54, v105, v101, s42
    v_perm_b32 v58, v105, v101, s43
    v_perm_b32 v62, v106, v102, s42
    v_perm_b32 v66, v106, v102, s43
    v_perm_b32 v70, v107, v103, s42
    v_perm_b32 v74, v107, v103, s43
    v_perm_b32 v47, v112, v108, s42
    v_perm_b32 v51, v112, v108, s43
    v_perm_b32 v55, v113, v109, s42
    v_perm_b32 v59, v113, v109, s43
    v_perm_b32 v63, v114, v110, s42
    v_perm_b32 v67, v114, v110, s43
    v_perm_b32 v71, v115, v111, s42
    v_perm_b32 v75, v115, v111, s43
    buffer_load_dwordx4 v[76:79], v2, s[24:27], s41 offen
    buffer_load_dwordx4 v[84:87], v1, s[20:23], s40 offen offset:0 nt
    buffer_load_dwordx4 v[88:91], v1, s[20:23], s40 offen offset:256 nt
    buffer_load_dwordx4 v[92:95], v1, s[20:23], s40 offen offset:512 nt
    buffer_load_dwordx4 v[96:99], v1, s[20:23], s40 offen offset:768 nt
    buffer_load_dwordx4 v[100:103], v1, s[20:23], s40 offen offset:1024 nt
    buffer_load_dwordx4 v[104:107], v1, s[20:23], s40 offen offset:1280 nt
    buffer_load_dwordx4 v[108:111], v1, s[20:23], s40 offen offset:1536 nt
    buffer_load_dwordx4 v[112:115], v1, s[20:23], s40 offen offset:1792 nt
    v_mfma_f32_16x16x32_bf16 v[12:15], v[152:155], v[44:47], v[12:15]
    v_mfma_f32_16x16x32_bf16 v[16:19], v[152:155], v[48:51], v[16:19]
    v_mfma_f32_16x16x32_bf16 v[20:23], v[152:155], v[52:55], v[20:23]
    v_mfma_f32_16x16x32_bf16 v[24:27], v[152:155], v[56:59], v[24:27]
    v_mfma_f32_16x16x32_bf16 v[28:31], v[152:155], v[60:63], v[28:31]
    v_mfma_f32_16x16x32_bf16 v[32:35], v[152:155], v[64:67], v[32:35]
    v_mfma_f32_16x16x32_bf16 v[36:39], v[152:155], v[68:71], v[36:39]
    v_mfma_f32_16x16x32_bf16 v[40:43], v[152:155], v[72:75], v[40:43]
    s_cmp_lt_u32 s39, 28
    s_cbranch_scc1 L_nograb0
    s_cmp_eq_u32 s72, 0
    s_cbranch_scc1 L_nograb0
    s_mov_b64 exec, 1
    global_atomic_add v148, v150, v151, s[70:71] sc0
    s_mov_b64 exec, -1
L_nograb0:
    s_cmp_eq_u32 s73, 0
    s_cbranch_scc1 L_vepi
    s_waitcnt vmcnt(9)
    s_cmp_lt_u32 s39, 29
    s_cbranch_scc1 L_static1
    v_readfirstlane_b32 s3, v149
    s_and_b32 s45, s3, 3
    s_lshl_b32 s45, s45, 6
    s_lshr_b32 s46, s3, 2
    s_add_u32 s45, s45, s46
    s_add_u32 s45, s45, 56
    s_cmp_lt_u32 s3, 32
    s_cselect_b32 s73, 1, 0
    s_cselect_b32 s22, 0x200000, 0
    s_cselect_b32 s26, 0x40000, 0
    s_branch L_join1
L_static1:
    s_add_u32 s45, s49, s48
    s_add_u32 s49, s49, 2
L_join1:
    s_lshl_b32 s40, s45, 13
    s_lshl_b32 s41, s45, 6
    v_mov_b32 v152, v80
    v_mov_b32 v153, v81
    v_mov_b32 v154, v82
    v_mov_b32 v155, v83
    v_perm_b32 v44, v120, v116, s42
    v_perm_b32 v48, v120, v116, s43
    v_perm_b32 v52, v121, v117, s42
    v_perm_b32 v56, v121, v117, s43
    v_perm_b32 v60, v122, v118, s42
    v_perm_b32 v64, v122, v118, s43
    v_perm_b32 v68, v123, v119, s42
    v_perm_b32 v72, v123, v119, s43
    v_perm_b32 v45, v128, v124, s42
    v_perm_b32 v49, v128, v124, s43
    v_perm_b32 v53, v129, v125, s42
    v_perm_b32 v57, v129, v125, s43
    v_perm_b32 v61, v130, v126, s42
    v_perm_b32 v65, v130, v126, s43
    v_perm_b32 v69, v131, v127, s42
    v_perm_b32 v73, v131, v127, s43
    v_perm_b32 v46, v136, v132, s42
    v_perm_b32 v50, v136, v132, s43
    v_perm_b32 v54, v137, v133, s42
    v_perm_b32 v58, v137, v133, s43
    v_perm_b32 v62, v138, v134, s42
    v_perm_b32 v66, v138, v134, s43
    v_perm_b32 v70, v139, v135, s42
    v_perm_b32 v74, v139, v135, s43
    v_perm_b32 v47, v144, v140, s42
    v_perm_b32 v51, v144, v140, s43
    v_perm_b32 v55, v145, v141, s42
    v_perm_b32 v59, v145, v141, s43
    v_perm_b32 v63, v146, v142, s42
    v_perm_b32 v67, v146, v142, s43
    v_perm_b32 v71, v147, v143, s42
    v_perm_b32 v75, v147, v143, s43
    buffer_load_dwordx4 v[80:83], v2, s[24:27], s41 offen
    buffer_load_dwordx4 v[116:119], v1, s[20:23], s40 offen offset:0 nt
    buffer_load_dwordx4 v[120:123], v1, s[20:23], s40 offen offset:256 nt
    buffer_load_dwordx4 v[124:127], v1, s[20:23], s40 offen offset:512 nt
    buffer_load_dwordx4 v[128:131], v1, s[20:23], s40 offen offset:768 nt
    buffer_load_dwordx4 v[132:135], v1, s[20:23], s40 offen offset:1024 nt
    buffer_load_dwordx4 v[136:139], v1, s[20:23], s40 offen offset:1280 nt
    buffer_load_dwordx4 v[140:143], v1, s[20:23], s40 offen offset:1536 nt
    buffer_load_dwordx4 v[144:147], v1, s[20:23], s40 offen offset:1792 nt
    v_mfma_f32_16x16x32_bf16 v[12:15], v[152:155], v[44:47], v[12:15]
    v_mfma_f32_16x16x32_bf16 v[16:19], v[152:155], v[48:51], v[16:19]
    v_mfma_f32_16x16x32_bf16 v[20:23], v[152:155], v[52:55], v[20:23]
    v_mfma_f32_16x16x32_bf16 v[24:27], v[152:155], v[56:59], v[24:27]
    v_mfma_f32_16x16x32_bf16 v[28:31], v[152:155], v[60:63], v[28:31]
    v_mfma_f32_16x16x32_bf16 v[32:35], v[152:155], v[64:67], v[32:35]
    v_mfma_f32_16x16x32_bf16 v[36:39], v[152:155], v[68:71], v[36:39]
    v_mfma_f32_16x16x32_bf16 v[40:43], v[152:155], v[72:75], v[40:43]
    s_cmp_lt_u32 s39, 28
    s_cbranch_scc1 L_nograb1
    s_cmp_eq_u32 s73, 0
    s_cbranch_scc1 L_nograb1
    s_mov_b64 exec, 1
    global_atomic_add v149, v150, v151, s[70:71] sc0
    s_mov_b64 exec, -1
L_nograb1:
    s_cmp_eq_u32 s39, 15
    s_cbranch_scc0 L_nokepi
    v_lshlrev_b32 v44, 16, v8
    v_and_b32 v45, 0xffff0000, v8
    v_lshlrev_b32 v46, 16, v9
    v_and_b32 v47, 0xffff0000, v9
    v_lshlrev_b32 v48, 16, v10
    v_and_b32 v49, 0xffff0000, v10
    v_lshlrev_b32 v50, 16, v11
    v_and_b32 v51, 0xffff0000, v11
    s_nop 7
    v_mul_f32 v52, v44, v12
    v_mul_f32 v53, v44, v13
    v_mul_f32 v54, v44, v14
    v_mul_f32 v55, v44, v15
    v_fmac_f32 v52, v45, v16
    v_fmac_f32 v53, v45, v17
    v_fmac_f32 v54, v45, v18
    v_fmac_f32 v55, v45, v19
    v_fmac_f32 v52, v46, v20
    v_fmac_f32 v53, v46, v21
    v_fmac_f32 v54, v46, v22
    v_fmac_f32 v55, v46, v23
    v_fmac_f32 v52, v47, v24
    v_fmac_f32 v53, v47, v25
    v_fmac_f32 v54, v47, v26
    v_fmac_f32 v55, v47, v27
    v_fmac_f32 v52, v48, v28
    v_fmac_f32 v53, v48, v29
    v_fmac_f32 v54, v48, v30
    v_fmac_f32 v55, v48, v31
    v_fmac_f32 v52, v49, v32
    v_fmac_f32 v53, v49, v33
    v_fmac_f32 v54, v49, v34
    v_fmac_f32 v55, v49, v35
    v_fmac_f32 v52, v50, v36
    v_fmac_f32 v53, v50, v37
    v_fmac_f32 v54, v50, v38
    v_fmac_f32 v55, v50, v39
    v_fmac_f32 v52, v51, v40
    v_fmac_f32 v53, v51, v41
    v_fmac_f32 v54, v51, v42
    v_fmac_f32 v55, v51, v43
    v_mov_b32 v12, 0
    v_mov_b32 v13, 0
    v_mov_b32 v14, 0
    v_mov_b32 v15, 0
    v_mov_b32 v16, 0
    v_mov_b32 v17, 0
    v_mov_b32 v18, 0
    v_mov_b32 v19, 0
    v_mov_b32 v20, 0
    v_mov_b32 v21, 0
    v_mov_b32 v22, 0
    v_mov_b32 v23, 0
    v_mov_b32 v24, 0
    v_mov_b32 v25, 0
    v_mov_b32 v26, 0
    v_mov_b32 v27, 0
    v_mov_b32 v28, 0
    v_mov_b32 v29, 0
    v_mov_b32 v30, 0
    v_mov_b32 v31, 0
    v_mov_b32 v32, 0
    v_mov_b32 v33, 0
    v_mov_b32 v34, 0
    v_mov_b32 v35, 0
    v_mov_b32 v36, 0
    v_mov_b32 v37, 0
    v_mov_b32 v38, 0
    v_mov_b32 v39, 0
    v_mov_b32 v40, 0
    v_mov_b32 v41, 0
    v_mov_b32 v42, 0
    v_mov_b32 v43, 0
    v_add_f32_dpp v52, v52, v52 row_ror:8 row_mask:0xf bank_mask:0xf
    v_add_f32_dpp v53, v53, v53 row_ror:8 row_mask:0xf bank_mask:0xf
    v_add_f32_dpp v54, v54, v54 row_ror:8 row_mask:0xf bank_mask:0xf
    v_add_f32_dpp v55, v55, v55 row_ror:8 row_mask:0xf bank_mask:0xf
    v_add_f32_dpp v52, v52, v52 row_ror:4 row_mask:0xf bank_mask:0xf
    v_add_f32_dpp v53, v53, v53 row_ror:4 row_mask:0xf bank_mask:0xf
    v_add_f32_dpp v54, v54, v54 row_ror:4 row_mask:0xf bank_mask:0xf
    v_add_f32_dpp v55, v55, v55 row_ror:4 row_mask:0xf bank_mask:0xf
    v_add_f32_dpp v52, v52, v52 row_ror:2 row_mask:0xf bank_mask:0xf
    v_add_f32_dpp v53, v53, v53 row_ror:2 row_mask:0xf bank_mask:0xf
    v_add_f32_dpp v54, v54, v54 row_ror:2 row_mask:0xf bank_mask:0xf
    v_add_f32_dpp v55, v55, v55 row_ror:2 row_mask:0xf bank_mask:0xf
    v_add_f32_dpp v52, v52, v52 row_ror:1 row_mask:0xf bank_mask:0xf
    v_add_f32_dpp v53, v53, v53 row_ror:1 row_mask:0xf bank_mask:0xf
    v_add_f32_dpp v54, v54, v54 row_ror:1 row_mask:0xf bank_mask:0xf
    v_add_f32_dpp v55, v55, v55 row_ror:1 row_mask:0xf bank_mask:0xf
    v_lshrrev_b32 v3, 4, v0
    v_lshlrev_b32 v3, 4, v3
    s_lshl_b32 s45, s36, 6
    v_add_u32 v3, s45, v3
    ds_write_b128 v3, v[52:55] offset:128
    v_mov_b32 v4, 0
    v_mov_b32 v5, 1
    s_mov_b64 exec, 1
    ds_add_u32 v4, v5 offset:0
    s_mov_b64 exec, -1
L_nokepi:
    s_add_u32 s39, s39, 1
    s_branch L_loop
L_vepi:
    s_mov_b32 s50, 0
L_pchk:
    s_waitcnt lgkmcnt(0)
    v_cmp_eq_u32 vcc, -1, v8
    v_cmp_eq_u32 s[68:69], -1, v9
    s_or_b64 vcc, vcc, s[68:69]
    v_cmp_eq_u32 s[68:69], -1, v10
    s_or_b64 vcc, vcc, s[68:69]
    v_cmp_eq_u32 s[68:69], -1, v11
    s_or_b64 vcc, vcc, s[68:69]
    s_cmp_eq_u64 vcc, 0
    s_cbranch_scc1 L_pok
    s_add_u32 s50, s50, 1
    s_cmp_ge_u32 s50, 0x400000
    s_cbranch_scc1 L_pok
    s_sleep 1
    ds_read_b128 v[8:11], v6 offset:64
    s_branch L_pchk
L_pok:
    v_mul_f32 v52, v8, v12
    v_mul_f32 v53, v8, v16
    v_mul_f32 v54, v8, v20
    v_mul_f32 v55, v8, v24
    v_mul_f32 v56, v8, v28
    v_mul_f32 v57, v8, v32
    v_mul_f32 v58, v8, v36
    v_mul_f32 v59, v8, v40
    v_fmac_f32 v52, v9, v13
    v_fmac_f32 v53, v9, v17
    v_fmac_f32 v54, v9, v21
    v_fmac_f32 v55, v9, v25
    v_fmac_f32 v56, v9, v29
    v_fmac_f32 v57, v9, v33
    v_fmac_f32 v58, v9, v37
    v_fmac_f32 v59, v9, v41
    v_fmac_f32 v52, v10, v14
    v_fmac_f32 v53, v10, v18
    v_fmac_f32 v54, v10, v22
    v_fmac_f32 v55, v10, v26
    v_fmac_f32 v56, v10, v30
    v_fmac_f32 v57, v10, v34
    v_fmac_f32 v58, v10, v38
    v_fmac_f32 v59, v10, v42
    v_fmac_f32 v52, v11, v15
    v_fmac_f32 v53, v11, v19
    v_fmac_f32 v54, v11, v23
    v_fmac_f32 v55, v11, v27
    v_fmac_f32 v56, v11, v31
    v_fmac_f32 v57, v11, v35
    v_fmac_f32 v58, v11, v39
    v_fmac_f32 v59, v11, v43
    v_permlane32_swap_b32 v52, v56
    v_permlane32_swap_b32 v53, v57
    v_permlane32_swap_b32 v54, v58
    v_permlane32_swap_b32 v55, v59
    s_nop 0
    v_add_f32 v52, v52, v56
    v_add_f32 v53, v53, v57
    v_add_f32 v54, v54, v58
    v_add_f32 v55, v55, v59
    s_nop 0
    v_permlane16_swap_b32 v52, v54
    v_permlane16_swap_b32 v53, v55
    s_nop 1
    v_add_f32 v60, v52, v54
    v_add_f32 v61, v53, v55
    s_lshl_b32 s45, s36, 9
    v_lshlrev_b32 v3, 3, v0
    v_add_u32 v3, s45, v3
    ds_write_b64 v3, v[60:61] offset:2048
    s_waitcnt lgkmcnt(0)
    s_barrier
    s_endpgm
L_helper:
    v_mov_b32 v4, 0
    v_mov_b32 v5, 0
    ds_write_b64 v4, v[4:5] offset:0
    ds_write_b32 v4, v4 offset:8
    v_mov_b32 v8, -1
    v_and_b32 v7, 15, v0
    v_lshlrev_b32 v7, 2, v7
    ds_write_b32 v7, v8 offset:64
    s_mul_i32 s44, s37, 4
    s_add_u32 s44, s44, s38
    s_lshl_b32 s45, s44, 9
    s_add_u32 s45, s45, 65536
    v_lshlrev_b32 v1, 3, v0
    v_mov_b32 v8, -1
    v_mov_b32 v9, -1
    s_waitcnt lgkmcnt(0)
    s_barrier
    s_mov_b32 s20, s18
    s_and_b32 s21, s19, 0xffff
    s_mov_b32 s22, 0x100000
    buffer_store_dwordx2 v[8:9], v1, s[20:23], s45 offen sc1
    s_lshl_b32 s46, s44, 7
    v_lshlrev_b32 v7, 2, v0
    s_mov_b32 exec_hi, 0
    buffer_store_dword v8, v7, s[20:23], s46 offen sc1
    s_cmp_eq_u32 s38, 0
    s_cbranch_scc0 L_nocinit
    s_lshl_b32 s46, s37, 7
    s_add_u32 s46, s46, 196608
    buffer_store_dword v4, v7, s[20:23], s46 offen sc1
L_nocinit:
    s_mov_b64 exec, 1
    s_waitcnt vmcnt(0)
    s_lshl_b32 s47, s37, 2
    v_mov_b32 v10, s47
    v_mov_b32 v11, 1
    global_atomic_add v10, v11, s[16:17]
    s_mov_b64 exec, -1
L_hwaitk:
    s_sleep 8
    ds_read_b32 v6, v4 offset:0
    s_waitcnt lgkmcnt(0)
    v_readfirstlane_b32 s46, v6
    s_cmp_lt_u32 s46, 2
    s_cbranch_scc1 L_hwaitk
    v_and_b32 v6, 15, v0
    v_lshlrev_b32 v6, 2, v6
    ds_read_b32 v12, v6 offset:128
    ds_read_b32 v13, v6 offset:192
    s_waitcnt lgkmcnt(0)
    v_add_f32 v12, v12, v13
    v_mov_b32 v30, 0x7fc00000
    v_cmp_eq_u32 vcc, -1, v12
    s_lshl_b32 s46, s44, 7
    v_lshlrev_b32 v7, 2, v0
    v_cndmask_b32 v12, v12, v30, vcc
    s_mov_b32 exec_hi, 0
    buffer_store_dword v12, v7, s[20:23], s46 offen sc1
    s_mov_b64 exec, 1
    s_mov_b32 s50, 0
L_hwaits:
    global_load_dword v6, v10, s[16:17] sc1
    s_waitcnt vmcnt(0)
    v_readfirstlane_b32 s46, v6
    s_add_u32 s50, s50, 1
    s_cmp_ge_u32 s50, 0x100000
    s_cbranch_scc1 L_hgots
    s_cmp_ge_u32 s46, 4
    s_cbranch_scc1 L_hgots
    s_sleep 32
    s_branch L_hwaits
L_hgots:
    s_mov_b64 exec, -1
    v_mov_b32 v5, 1
    ds_write_b32 v4, v5 offset:8
L_hwaitv:
    s_sleep 8
    ds_read_b32 v6, v4 offset:4
    s_waitcnt lgkmcnt(0)
    v_readfirstlane_b32 s46, v6
    s_cmp_lt_u32 s46, 1
    s_cbranch_scc1 L_hwaitv
    v_lshrrev_b32 v6, 4, v0
    v_lshlrev_b32 v6, 7, v6
    v_and_b32 v7, 15, v0
    v_lshl_add_u32 v6, v7, 2, v6
    s_mul_i32 s46, s37, 512
    s_mov_b32 s50, 0
L_hgath:
    buffer_load_dword v12, v6, s[20:23], s46 offen sc1
    s_waitcnt vmcnt(0)
    v_cmp_eq_u32 vcc, -1, v12
    s_cmp_eq_u64 vcc, 0
    s_cbranch_scc1 L_hgathok
    s_add_u32 s50, s50, 1
    s_cmp_ge_u32 s50, 0x100000
    s_cbranch_scc1 L_hgathok
    s_sleep 32
    s_branch L_hgath
L_hgathok:
    v_mov_b32 v13, v12
    s_nop 1
    v_permlane32_swap_b32 v12, v13
    s_nop 1
    v_add_f32 v12, v12, v13
    v_mov_b32 v13, v12
    s_nop 1
    v_permlane16_swap_b32 v12, v13
    s_nop 1
    v_add_f32 v12, v12, v13
    s_mov_b32 s51, 0x3e0293ee
    v_mul_f32 v12, s51, v12
    v_mov_b32 v13, v12
    s_nop 1
    v_max_f32_dpp v13, v13, v13 row_ror:8 row_mask:0xf bank_mask:0xf
    s_nop 1
    v_max_f32_dpp v13, v13, v13 row_ror:4 row_mask:0xf bank_mask:0xf
    s_nop 1
    v_max_f32_dpp v13, v13, v13 row_ror:2 row_mask:0xf bank_mask:0xf
    s_nop 1
    v_max_f32_dpp v13, v13, v13 row_ror:1 row_mask:0xf bank_mask:0xf
    v_sub_f32 v12, v12, v13
    v_exp_f32 v12, v12
    s_nop 0
    v_mov_b32 v13, v12
    s_nop 1
    v_add_f32_dpp v13, v13, v13 row_ror:8 row_mask:0xf bank_mask:0xf
    s_nop 1
    v_add_f32_dpp v13, v13, v13 row_ror:4 row_mask:0xf bank_mask:0xf
    s_nop 1
    v_add_f32_dpp v13, v13, v13 row_ror:2 row_mask:0xf bank_mask:0xf
    s_nop 1
    v_add_f32_dpp v13, v13, v13 row_ror:1 row_mask:0xf bank_mask:0xf
    v_rcp_f32 v13, v13
    s_nop 0
    v_mul_f32 v12, v12, v13
    v_lshlrev_b32 v7, 2, v7
    v_cmp_eq_u32 vcc, -1, v12
    s_nop 1
    v_cndmask_b32 v12, v12, v30, vcc
    ds_write_b32 v7, v12 offset:64
    s_cmp_eq_u32 s38, 0
    s_cbranch_scc1 L_cons
    s_barrier
    ds_read_b64 v[12:13], v1 offset:2048
    ds_read_b64 v[14:15], v1 offset:2560
    v_mov_b32 v30, 0x7fc00000
    s_waitcnt lgkmcnt(0)
    v_add_f32 v12, v12, v14
    v_add_f32 v13, v13, v15
    v_cmp_eq_u32 vcc, -1, v12
    v_cmp_eq_u32 s[50:51], -1, v13
    s_nop 1
    v_cndmask_b32 v12, v12, v30, vcc
    v_cndmask_b32 v13, v13, v30, s[50:51]
    buffer_store_dwordx2 v[12:13], v1, s[20:23], s45 offen sc1
    s_endpgm
L_cons:
    buffer_load_dwordx2 v[32:33], v1, s[20:23], s45 offen offset:512 sc1
    buffer_load_dwordx2 v[34:35], v1, s[20:23], s45 offen offset:1024 sc1
    buffer_load_dwordx2 v[36:37], v1, s[20:23], s45 offen offset:1536 sc1
    v_and_b32 v6, 15, v0
    v_lshrrev_b32 v7, 4, v0
    v_lshl_add_u32 v6, v6, 2, v7
    v_lshlrev_b32 v6, 2, v6
    s_mov_b32 s28, s14
    s_and_b32 s29, s15, 0xffff
    s_mov_b32 s30, 16384
    s_lshl_b32 s46, s37, 8
    s_mov_b32 s50, 0
    s_barrier
    ds_read_b64 v[12:13], v1 offset:2048
    ds_read_b64 v[14:15], v1 offset:2560
    s_waitcnt lgkmcnt(0)
    v_add_f32 v12, v12, v14
    v_add_f32 v13, v13, v15
L_fpoll:
    s_waitcnt vmcnt(0)
    v_cmp_eq_u32 vcc, -1, v32
    v_cmp_eq_u32 s[68:69], -1, v33
    s_or_b64 vcc, vcc, s[68:69]
    v_cmp_eq_u32 s[68:69], -1, v34
    s_or_b64 vcc, vcc, s[68:69]
    v_cmp_eq_u32 s[68:69], -1, v35
    s_or_b64 vcc, vcc, s[68:69]
    v_cmp_eq_u32 s[68:69], -1, v36
    s_or_b64 vcc, vcc, s[68:69]
    v_cmp_eq_u32 s[68:69], -1, v37
    s_or_b64 vcc, vcc, s[68:69]
    s_cmp_eq_u64 vcc, 0
    s_cbranch_scc1 L_fgot
    s_add_u32 s50, s50, 1
    s_cmp_ge_u32 s50, 0x100000
    s_cbranch_scc1 L_fgot
    buffer_load_dwordx2 v[32:33], v1, s[20:23], s45 offen offset:512 sc1
    buffer_load_dwordx2 v[34:35], v1, s[20:23], s45 offen offset:1024 sc1
    buffer_load_dwordx2 v[36:37], v1, s[20:23], s45 offen offset:1536 sc1
    s_branch L_fpoll
L_fgot:
    v_add_f32 v12, v12, v32
    v_add_f32 v13, v13, v33
    v_add_f32 v12, v12, v34
    v_add_f32 v13, v13, v35
    v_add_f32 v12, v12, v36
    v_add_f32 v13, v13, v37
    v_cvt_pk_bf16_f32 v12, v12, v13
    buffer_store_dword v12, v6, s[28:31], s46 offen
L_end:
    s_endpgm
.section .rodata,"a"
.p2align 6
.amdhsa_kernel standalone__low_rank_proj_linformer__decode_kernel
  .amdhsa_next_free_vgpr 156
  .amdhsa_next_free_sgpr 80
  .amdhsa_accum_offset 156
  .amdhsa_group_segment_fixed_size 0
  .amdhsa_kernarg_size 64
  .amdhsa_user_sgpr_count 2
  .amdhsa_user_sgpr_kernarg_segment_ptr 1
  .amdhsa_system_sgpr_workgroup_id_x 1
  .amdhsa_float_denorm_mode_32 3
.end_amdhsa_kernel
```
